```python
import torch

def _softmax(x, axis=-1):
    return torch.softmax(x, dim=axis)
def _gelu(x):
    return torch.nn.functional.gelu(x, approximate="tanh")
def _silu(x):
    return torch.nn.functional.silu(x)
def _sigmoid(x):
    return torch.sigmoid(x)
def _layernorm(x, axis=-1, eps=1e-5):
    m = x.mean(dim=axis, keepdim=True)
    v = x.var(dim=axis, keepdim=True, unbiased=False)
    return (x - m) / torch.sqrt(v + eps)
def _scatter_add(tgt, idx, src, axis=0):
    return tgt.clone().index_add_(axis, idx, src)
def _segment_sum(src, seg, n):
    out = torch.zeros((n,) + src.shape[1:], dtype=src.dtype)
    return out.index_add_(0, seg, src)
def _pad(x, pw):
    flat = tuple(v for pair in reversed(pw) for v in pair)
    return torch.nn.functional.pad(x, flat)

kernel_name = 'standalone__geglu_ffn__decode'

def setup_inputs():

    _w = (lambda a: (lambda t: t.to(torch.bfloat16) if t.is_floating_point() else t)(torch.as_tensor(a)))
    B, S, D, F = 1, 1, 1024, 3584
    return {
        "x": _w((lambda *s: torch.randn(*s, dtype=torch.bfloat16) * 0.05)(B, S, D)),
        "w_gate": _w((lambda *s: torch.randn(*s, dtype=torch.bfloat16) * 0.05)(D, F)),
        "w_up": _w((lambda *s: torch.randn(*s, dtype=torch.bfloat16) * 0.05)(D, F)),
        "w_down": _w((lambda *s: torch.randn(*s, dtype=torch.bfloat16) * 0.05)(F, D)),
    }

def reference(x, w_gate, w_up, w_down):
    return (_gelu(x @ w_gate) * (x @ w_up)) @ w_down
```

```asm
; @launch grid=(256,1,1) block=(256,1,1) lds=8192
.amdgcn_target "amdgcn-amd-amdhsa--gfx950"
.text
.globl standalone__geglu_ffn__decode_kernel
.p2align 12
.p2align 8
.type standalone__geglu_ffn__decode_kernel,@function
standalone__geglu_ffn__decode_kernel:
    s_load_dwordx8 s[4:11], s[0:1], 0
    s_load_dwordx4 s[12:15], s[0:1], 32
    s_load_dwordx2 s[16:17], s[0:1], 48
    s_cmp_ge_u32 s2, 256
    s_cbranch_scc1 L_exit
    s_getpc_b64 s[20:21]
    v_lshlrev_b32 v1, 7, v0
    v_cmp_gt_u32 vcc, 3200, v1
    s_and_saveexec_b64 s[22:23], vcc
    s_cbranch_execz L_nopf
    global_load_dword v197, v1, s[20:21]
L_nopf:
    s_mov_b64 exec, -1
    v_lshrrev_b32 v7, 6, v0
    s_lshr_b32 s18, s2, 3
    s_and_b32 s19, s2, 7
    v_readfirstlane_b32 s29, v7
    s_getreg_b32 s45, hwreg(HW_REG_XCC_ID, 0, 4)
    s_add_u32 s45, s45, 1
    s_cmp_lt_u32 s18, 28
    s_cbranch_scc1 L_prod
    s_sub_u32 s18, s18, 28
    s_lshl_b32 s27, s19, 4
    s_lshl_b32 s28, s18, 2
    s_add_u32 s27, s27, s28
    v_mov_b32 v5, s27
    v_mov_b32 v6, s45
    s_lshr_b32 s26, s19, 1
    s_lshl_b32 s27, s26, 2
    s_add_u32 s27, s27, s18
    s_lshl_b32 s27, s27, 2
    s_add_u32 s27, s27, s29
    s_mul_i32 s27, s27, 114688
    s_add_u32 s27, s27, 88064
    v_bfe_u32 v2, v0, 4, 2
    v_mul_u32_u24 v2, 7168, v2
    v_and_b32 v1, 15, v0
    v_lshl_add_u32 v2, v1, 4, v2
    s_bitcmp1_b32 s19, 0
    v_cmp_eq_u32 vcc, 0, v0
    s_waitcnt lgkmcnt(0)
    s_load_dwordx2 s[22:23], s[16:17], 0
    s_cbranch_vccz L_noxi
    s_mov_b64 exec, 1
    global_store_dword v5, v6, s[14:15] sc1
    s_mov_b64 exec, -1
L_noxi:
    s_cselect_b64 s[20:21], s[8:9], s[6:7]
    s_sub_u32 s28, 0x100, s20
    s_and_b32 s28, s28, 0x300
    s_add_u32 s27, s27, s28
    v_add_u32 v2, s27, v2
    v_add_u32 v3, 4096, v2
    global_load_dwordx4 v[32:35], v2, s[20:21] offset:-2048
    global_load_dwordx4 v[32:35], v2, s[20:21] offset:-1024
    global_load_dwordx4 v[32:35], v2, s[20:21] offset:0
    global_load_dwordx4 v[32:35], v2, s[20:21] offset:1024
    global_load_dwordx4 v[32:35], v3, s[20:21] offset:-2048
    global_load_dwordx4 v[32:35], v3, s[20:21] offset:-1024
    global_load_dwordx4 v[32:35], v3, s[20:21] offset:0
    v_subrev_u32 v2, 28672, v2
    v_add_u32 v3, 4096, v2
    global_load_dwordx4 v[32:35], v2, s[20:21] offset:-2048
    global_load_dwordx4 v[32:35], v2, s[20:21] offset:-1024
    global_load_dwordx4 v[32:35], v2, s[20:21] offset:0
    global_load_dwordx4 v[32:35], v2, s[20:21] offset:1024
    global_load_dwordx4 v[32:35], v3, s[20:21] offset:-2048
    global_load_dwordx4 v[32:35], v3, s[20:21] offset:-1024
    global_load_dwordx4 v[32:35], v3, s[20:21] offset:0
    s_branch L_cons
L_prod:
    v_and_b32 v1, 15, v0
    v_lshrrev_b32 v2, 4, v0
    s_lshr_b32 s26, s19, 1
    s_lshl_b32 s27, s26, 9
    v_lshl_add_u32 v3, v2, 5, s27
    s_mul_i32 s27, s26, 1835008
    s_lshl_b32 s28, s18, 8
    s_add_u32 s27, s27, s28
    v_mul_u32_u24 v4, 114688, v2
    v_lshl_add_u32 v4, v1, 4, v4
    v_add_u32 v8, s27, v4
    v_add_u32 v9, 7168, v8
    v_add_u32 v10, 14336, v8
    v_add_u32 v11, 21504, v8
    v_add_u32 v12, 28672, v8
    v_add_u32 v13, 35840, v8
    v_add_u32 v14, 43008, v8
    v_add_u32 v15, 50176, v8
    v_add_u32 v16, 57344, v8
    v_add_u32 v17, 64512, v8
    v_add_u32 v18, 71680, v8
    v_add_u32 v19, 78848, v8
    v_add_u32 v20, 86016, v8
    v_add_u32 v21, 93184, v8
    v_add_u32 v22, 100352, v8
    v_add_u32 v23, 107520, v8
    s_bitcmp1_b32 s19, 0
    s_waitcnt lgkmcnt(0)
    s_cselect_b64 s[20:21], s[8:9], s[6:7]
    global_load_dwordx4 v[24:27], v3, s[4:5]
    global_load_dwordx4 v[28:31], v3, s[4:5] offset:16
    global_load_dwordx4 v[64:67], v8, s[20:21] nt
    global_load_dwordx4 v[68:71], v9, s[20:21] nt
    global_load_dwordx4 v[72:75], v10, s[20:21] nt
    global_load_dwordx4 v[76:79], v11, s[20:21] nt
    global_load_dwordx4 v[80:83], v12, s[20:21] nt
    global_load_dwordx4 v[84:87], v13, s[20:21] nt
    global_load_dwordx4 v[88:91], v14, s[20:21] nt
    global_load_dwordx4 v[92:95], v15, s[20:21] nt
    s_barrier
    global_load_dwordx4 v[96:99], v16, s[20:21] nt
    global_load_dwordx4 v[100:103], v17, s[20:21] nt
    global_load_dwordx4 v[104:107], v18, s[20:21] nt
    global_load_dwordx4 v[108:111], v19, s[20:21] nt
    global_load_dwordx4 v[112:115], v20, s[20:21] nt
    global_load_dwordx4 v[116:119], v21, s[20:21] nt
    global_load_dwordx4 v[120:123], v22, s[20:21] nt
    global_load_dwordx4 v[124:127], v23, s[20:21] nt
    s_load_dwordx2 s[22:23], s[16:17], 0
    v_bfe_u32 v8, v0, 3, 1
    v_mul_u32_u24 v8, 0x202, v8
    v_add_u32 v8, 0x100, v8
    v_lshlrev_b32 v9, 16, v8
    v_or_b32 v9, 0x0c0c, v9
    v_or_b32 v8, 0x0c0c0000, v8
    v_and_b32 v10, 1, v0
    v_cmp_eq_u32 vcc, 1, v10
    v_bfe_u32 v10, v0, 1, 2
    v_mov_b32 v11, 0x0c0c0c0c
    v_cndmask_b32 v8, v8, v9, vcc
    v_cmp_eq_u32 vcc, 0, v10
    s_nop 1
    v_cndmask_b32 v184, v11, v8, vcc
    v_cmp_eq_u32 vcc, 1, v10
    s_nop 1
    v_cndmask_b32 v185, v11, v8, vcc
    v_cmp_eq_u32 vcc, 2, v10
    s_nop 1
    v_cndmask_b32 v186, v11, v8, vcc
    v_cmp_eq_u32 vcc, 3, v10
    s_nop 1
    v_cndmask_b32 v187, v11, v8, vcc
    v_and_b32 v191, 63, v0
    v_lshlrev_b32 v191, 3, v191
    s_mul_i32 s27, s19, 28
    s_add_u32 s28, s27, s18
    s_lshl_b32 s28, s28, 10
    s_add_u32 s28, s28, 4096
    v_lshl_add_u32 v194, v191, 1, s28
    s_lshl_b32 s30, s19, 4
    v_and_b32 v9, 3, v0
    v_lshl_add_u32 v195, v9, 2, s30
    s_lshl_b32 s27, s2, 10
    s_add_u32 s27, s27, 262144
    v_lshl_add_u32 v192, v191, 1, s27
    s_lshl_b32 s27, s18, 13
    s_add_u32 s27, s27, 262144
    v_lshl_add_u32 v193, v2, 6, s27
    v_bfe_u32 v10, v0, 2, 2
    v_lshl_add_u32 v193, v10, 11, v193
    v_bfe_i32 v10, v0, 2, 1
    v_xor_b32 v9, v9, v10
    v_and_b32 v9, 3, v9
    v_lshl_add_u32 v193, v9, 4, v193
    v_lshrrev_b32 v9, 5, v0
    v_lshlrev_b32 v190, 9, v9
    v_lshl_add_u32 v190, v1, 5, v190
    v_and_b32 v9, 16, v0
    v_add_u32 v190, v9, v190
    s_lshl_b32 s27, s18, 18
    s_lshl_b32 s28, s19, 8
    s_add_u32 s27, s27, s28
    s_add_u32 s27, s27, 4096
    v_lshlrev_b32 v4, 14, v2
    v_lshl_add_u32 v4, v1, 4, v4
    v_add_u32 v188, s27, v4
    v_add_u32 v189, 8192, v188
    s_mov_b32 s44, 0x40000
    v_mov_b32 v178, 0
    v_mov_b32 v182, 0
    v_mov_b32 v160, 0
    v_mov_b32 v161, 0
    v_mov_b32 v162, 0
    v_mov_b32 v163, 0
    v_mov_b32 v164, 0
    v_mov_b32 v165, 0
    v_mov_b32 v166, 0
    v_mov_b32 v167, 0
    v_mov_b32 v168, 0
    v_mov_b32 v169, 0
    v_mov_b32 v170, 0
    v_mov_b32 v171, 0
    v_mov_b32 v172, 0
    v_mov_b32 v173, 0
    v_mov_b32 v174, 0
    v_mov_b32 v175, 0
    s_waitcnt vmcnt(16)
    v_perm_b32 v32, v24, v24, v184
    v_perm_b32 v33, v24, v24, v185
    v_perm_b32 v34, v24, v24, v186
    v_perm_b32 v35, v24, v24, v187
    v_perm_b32 v36, v25, v25, v184
    v_perm_b32 v37, v25, v25, v185
    v_perm_b32 v38, v25, v25, v186
    v_perm_b32 v39, v25, v25, v187
    v_perm_b32 v40, v26, v26, v184
    v_perm_b32 v41, v26, v26, v185
    v_perm_b32 v42, v26, v26, v186
    v_perm_b32 v43, v26, v26, v187
    v_perm_b32 v44, v27, v27, v184
    v_perm_b32 v45, v27, v27, v185
    v_perm_b32 v46, v27, v27, v186
    v_perm_b32 v47, v27, v27, v187
    v_perm_b32 v48, v28, v28, v184
    v_perm_b32 v49, v28, v28, v185
    v_perm_b32 v50, v28, v28, v186
    v_perm_b32 v51, v28, v28, v187
    v_perm_b32 v52, v29, v29, v184
    v_perm_b32 v53, v29, v29, v185
    v_perm_b32 v54, v29, v29, v186
    v_perm_b32 v55, v29, v29, v187
    v_perm_b32 v56, v30, v30, v184
    v_perm_b32 v57, v30, v30, v185
    v_perm_b32 v58, v30, v30, v186
    v_perm_b32 v59, v30, v30, v187
    v_perm_b32 v60, v31, v31, v184
    v_perm_b32 v61, v31, v31, v185
    v_perm_b32 v62, v31, v31, v186
    v_perm_b32 v63, v31, v31, v187
    s_waitcnt vmcnt(15)
    v_mfma_f32_16x16x32_bf16 v[160:163], v[32:35], v[64:67], v[160:163]
    s_waitcnt vmcnt(14)
    v_mfma_f32_16x16x32_bf16 v[164:167], v[32:35], v[68:71], v[164:167]
    s_waitcnt vmcnt(13)
    v_mfma_f32_16x16x32_bf16 v[160:163], v[36:39], v[72:75], v[160:163]
    s_waitcnt vmcnt(12)
    v_mfma_f32_16x16x32_bf16 v[164:167], v[36:39], v[76:79], v[164:167]
    s_waitcnt vmcnt(11)
    v_mfma_f32_16x16x32_bf16 v[160:163], v[40:43], v[80:83], v[160:163]
    s_waitcnt vmcnt(10)
    v_mfma_f32_16x16x32_bf16 v[164:167], v[40:43], v[84:87], v[164:167]
    s_waitcnt vmcnt(9)
    v_mfma_f32_16x16x32_bf16 v[160:163], v[44:47], v[88:91], v[160:163]
    s_waitcnt vmcnt(8)
    v_mfma_f32_16x16x32_bf16 v[164:167], v[44:47], v[92:95], v[164:167]
    s_waitcnt vmcnt(7)
    v_mfma_f32_16x16x32_bf16 v[160:163], v[48:51], v[96:99], v[160:163]
    global_load_dwordx4 v[128:131], v188, s[10:11] offset:-4096 nt
    s_waitcnt vmcnt(7)
    v_mfma_f32_16x16x32_bf16 v[164:167], v[48:51], v[100:103], v[164:167]
    global_load_dwordx4 v[132:135], v188, s[10:11] offset:-2048 nt
    s_waitcnt vmcnt(7)
    v_mfma_f32_16x16x32_bf16 v[160:163], v[52:55], v[104:107], v[160:163]
    global_load_dwordx4 v[136:139], v188, s[10:11] offset:0 nt
    s_waitcnt vmcnt(7)
    v_mfma_f32_16x16x32_bf16 v[164:167], v[52:55], v[108:111], v[164:167]
    global_load_dwordx4 v[140:143], v188, s[10:11] offset:2048 nt
    s_waitcnt vmcnt(7)
    v_mfma_f32_16x16x32_bf16 v[160:163], v[56:59], v[112:115], v[160:163]
    global_load_dwordx4 v[144:147], v189, s[10:11] offset:-4096 nt
    s_waitcnt vmcnt(7)
    v_mfma_f32_16x16x32_bf16 v[164:167], v[56:59], v[116:119], v[164:167]
    s_waitcnt vmcnt(6)
    v_mfma_f32_16x16x32_bf16 v[160:163], v[60:63], v[120:123], v[160:163]
    s_waitcnt vmcnt(5)
    v_mfma_f32_16x16x32_bf16 v[164:167], v[60:63], v[124:127], v[164:167]
    s_nop 0
    s_mov_b32 exec_hi, 0
    s_nop 4
    ds_write_b128 v190, v[160:163] offset:0
    s_not_b64 exec, exec
    ds_write_b128 v190, v[164:167] offset:0
    s_mov_b64 exec, -1
    s_cmp_lg_u32 s29, 0
    s_waitcnt lgkmcnt(0)
    s_barrier
    s_cbranch_scc1 L_p1start
    ds_read_b64 v[8:9], v191 offset:0
    ds_read_b64 v[10:11], v191 offset:512
    ds_read_b64 v[12:13], v191 offset:1024
    ds_read_b64 v[14:15], v191 offset:1536
    ds_read_b64 v[16:17], v191 offset:2048
    ds_read_b64 v[18:19], v191 offset:2560
    ds_read_b64 v[20:21], v191 offset:3072
    ds_read_b64 v[22:23], v191 offset:3584
    s_add_u32 s24, s22, 2
    s_or_b32 s24, s24, 1
    s_add_u32 s25, s23, 0x9e3779b9
    v_mov_b32 v6, s24
    v_mov_b32 v7, s25
    s_waitcnt lgkmcnt(4)
    v_pk_add_f32 v[8:9], v[8:9], v[10:11]
    v_pk_add_f32 v[12:13], v[12:13], v[14:15]
    s_waitcnt lgkmcnt(0)
    v_pk_add_f32 v[16:17], v[16:17], v[18:19]
    v_pk_add_f32 v[20:21], v[20:21], v[22:23]
    v_pk_add_f32 v[8:9], v[8:9], v[12:13]
    v_pk_add_f32 v[16:17], v[16:17], v[20:21]
    v_pk_add_f32 v[4:5], v[8:9], v[16:17]
    global_store_dwordx4 v192, v[4:7], s[16:17] sc1
    global_load_dword v196, v195, s[14:15] sc1
L_p1start:
    s_barrier
    global_load_dwordx4 v[148:151], v189, s[10:11] offset:-2048 nt
    global_load_dwordx4 v[152:155], v189, s[10:11] offset:0 nt
    global_load_dwordx4 v[156:159], v189, s[10:11] offset:2048 nt
    s_cmp_eq_u32 s29, 0
    s_cbranch_scc1 L_eb
    s_waitcnt vmcnt(3)
L_eb:
    s_add_u32 s24, s22, 2
    s_or_b32 s24, s24, 1
    s_add_u32 s25, s23, 0x9e3779b9
    v_mov_b32 v23, 0xc0135761
    s_barrier
L_poll1:
    global_load_dwordx4 v[176:179], v193, s[16:17] sc1
    global_load_dwordx4 v[180:183], v193, s[16:17] offset:1024 sc1
    s_mov_b32 s46, 6
L_chk1:
    v_cmp_eq_u64 vcc, s[24:25], v[178:179]
    v_cmp_eq_u64 s[30:31], s[24:25], v[182:183]
    s_and_b64 vcc, vcc, s[30:31]
    s_cmp_eq_u64 vcc, -1
    s_cbranch_scc1 L_done1
    s_sub_u32 s46, s46, 1
    s_cbranch_scc0 L_chk1
    s_sub_u32 s44, s44, 1
    s_cbranch_scc0 L_poll1
L_done1:
    v_add_f32_dpp v20, v176, v176 row_ror:8 row_mask:0xf bank_mask:0x3
    v_add_f32_dpp v20, v177, v177 row_ror:8 row_mask:0xf bank_mask:0xc
    v_add_f32_dpp v22, v180, v180 row_ror:8 row_mask:0xf bank_mask:0x3
    v_add_f32_dpp v22, v181, v181 row_ror:8 row_mask:0xf bank_mask:0xc
    v_add_f32_dpp v20, v20, v20 row_half_mirror row_mask:0xf bank_mask:0xf
    v_cvt_pk_bf16_f32 v21, 0, v20
    v_mul_f32 v24, v21, v21
    v_fmac_f32 v23, 0xbdd2d3e8, v24
    v_mul_f32 v24, v23, v21
    v_exp_f32 v24, v24
    v_add_f32_dpp v22, v22, v22 row_half_mirror row_mask:0xf bank_mask:0xf
    v_add_f32 v24, 1.0, v24
    v_rcp_f32 v24, v24
    v_cvt_pk_bf16_f32 v22, 0, v22
    v_mul_f32 v24, v24, v21
    v_cvt_pk_bf16_f32 v24, 0, v24
    v_mul_f32 v24, v24, v22
    s_nop 1
    v_mov_b32_dpp v25, v24 row_ror:8 row_mask:0xf bank_mask:0xf
    v_cvt_pk_bf16_f32 v24, v24, v25
    s_nop 1
    v_mov_b32_dpp v26, v24 row_newbcast:0 row_mask:0xf bank_mask:0xf
    v_perm_b32 v32, v26, v26, v184
    v_perm_b32 v33, v26, v26, v185
    v_perm_b32 v34, v26, v26, v186
    v_perm_b32 v35, v26, v26, v187
    v_mov_b32_dpp v27, v24 row_newbcast:1 row_mask:0xf bank_mask:0xf
    v_mov_b32_dpp v28, v24 row_newbcast:2 row_mask:0xf bank_mask:0xf
    v_mfma_f32_16x16x32_bf16 v[168:171], v[32:35], v[128:131], v[168:171]
    v_mov_b32_dpp v29, v24 row_newbcast:3 row_mask:0xf bank_mask:0xf
    v_perm_b32 v36, v27, v27, v184
    v_mfma_f32_16x16x32_bf16 v[172:175], v[32:35], v[132:135], v[172:175]
    v_perm_b32 v37, v27, v27, v185
    v_perm_b32 v38, v27, v27, v186
    v_perm_b32 v39, v27, v27, v187
    v_perm_b32 v40, v28, v28, v184
    v_perm_b32 v41, v28, v28, v185
    v_mfma_f32_16x16x32_bf16 v[168:171], v[36:39], v[136:139], v[168:171]
    v_perm_b32 v42, v28, v28, v186
    v_perm_b32 v43, v28, v28, v187
    v_mfma_f32_16x16x32_bf16 v[172:175], v[36:39], v[140:143], v[172:175]
    v_perm_b32 v44, v29, v29, v184
    v_perm_b32 v45, v29, v29, v185
    v_mfma_f32_16x16x32_bf16 v[168:171], v[40:43], v[144:147], v[168:171]
    v_perm_b32 v46, v29, v29, v186
    v_perm_b32 v47, v29, v29, v187
    v_mfma_f32_16x16x32_bf16 v[172:175], v[40:43], v[148:151], v[172:175]
    s_nop 0
    v_mfma_f32_16x16x32_bf16 v[168:171], v[44:47], v[152:155], v[168:171]
    v_mfma_f32_16x16x32_bf16 v[172:175], v[44:47], v[156:159], v[172:175]
    s_mov_b32 exec_hi, 0
    s_nop 5
    ds_write_b128 v190, v[168:171] offset:4096
    s_not_b64 exec, exec
    ds_write_b128 v190, v[172:175] offset:4096
    s_mov_b64 exec, -1
    s_cmp_lg_u32 s29, 0
    s_waitcnt lgkmcnt(0)
    s_barrier
    s_cbranch_scc1 L_end
    ds_read_b64 v[8:9], v191 offset:4096
    ds_read_b64 v[10:11], v191 offset:4608
    ds_read_b64 v[12:13], v191 offset:5120
    ds_read_b64 v[14:15], v191 offset:5632
    ds_read_b64 v[16:17], v191 offset:6144
    ds_read_b64 v[18:19], v191 offset:6656
    ds_read_b64 v[20:21], v191 offset:7168
    ds_read_b64 v[22:23], v191 offset:7680
    v_cmp_eq_u32 vcc, s45, v196
    s_cmp_eq_u64 vcc, -1
    s_waitcnt lgkmcnt(4)
    v_pk_add_f32 v[8:9], v[8:9], v[10:11]
    v_pk_add_f32 v[12:13], v[12:13], v[14:15]
    s_waitcnt lgkmcnt(0)
    v_pk_add_f32 v[16:17], v[16:17], v[18:19]
    v_pk_add_f32 v[20:21], v[20:21], v[22:23]
    v_pk_add_f32 v[8:9], v[8:9], v[12:13]
    v_pk_add_f32 v[16:17], v[16:17], v[20:21]
    v_pk_add_f32 v[4:5], v[8:9], v[16:17]
    s_cbranch_scc0 L_slowpub
    global_store_dwordx4 v194, v[4:7], s[16:17]
    s_branch L_end
L_slowpub:
    global_store_dwordx4 v194, v[4:7], s[16:17] sc1
    s_branch L_end
L_cons:
    s_mul_i32 s27, s19, 28672
    s_lshl_b32 s28, s18, 8
    s_add_u32 s27, s27, s28
    s_lshl_b32 s28, s29, 6
    s_add_u32 s27, s27, s28
    s_add_u32 s27, s27, 4096
    v_bfe_u32 v1, v0, 2, 4
    v_and_b32 v2, 3, v0
    v_lshlrev_b32 v3, 11, v1
    v_lshl_add_u32 v3, v2, 4, v3
    v_add_u32 v3, s27, v3
    s_lshl_b32 s27, s19, 8
    s_lshl_b32 s28, s18, 6
    s_add_u32 s27, s27, s28
    s_lshl_b32 s28, s29, 4
    s_add_u32 s27, s27, s28
    v_lshl_add_u32 v4, v2, 2, s27
    v_bfe_u32 v19, v0, 5, 1
    v_lshl_add_u32 v4, v19, 1, v4
    s_mov_b32 s38, 0xf
    s_mov_b32 s39, 0xf
    v_mov_b32 v16, 0
    v_mov_b32 v17, 0
    v_mov_b32 v18, 0
    v_and_b32 v7, 31, v0
    v_lshlrev_b32 v7, 2, v7
    s_mov_b32 s44, 0x40000
    s_waitcnt lgkmcnt(0)
    s_add_u32 s24, s22, 2
    s_or_b32 s24, s24, 1
    s_add_u32 s25, s23, 0x9e3779b9
    s_barrier
    s_cmp_lg_u32 s29, 0
    s_cbranch_scc1 L_cpoll
    s_mov_b64 exec, 1
    global_store_dword v5, v6, s[14:15] offset:128 sc1
    s_mov_b64 exec, -1
L_cpoll:
    s_mov_b32 exec_hi, 0x00ffffff
L_slowpoll:
    global_load_dwordx4 v[8:11], v3, s[16:17] sc1
    global_load_dwordx4 v[12:15], v3, s[16:17] offset:1024 sc1
    s_waitcnt vmcnt(0)
    v_cmp_eq_u64 vcc, s[24:25], v[10:11]
    v_cmp_eq_u64 s[30:31], s[24:25], v[14:15]
    s_or_b64 vcc, vcc, s[30:31]
    s_cbranch_scc1 L_fastp
    s_sub_u32 s44, s44, 1
    s_cbranch_scc0 L_slowpoll
L_fastp:
    s_lshl_b32 s36, s29, 8
    s_add_u32 s36, s36, s2
    s_cmp_lg_u32 s36, 224
    s_cbranch_scc1 L_poll2
    global_load_dword v18, v7, s[14:15] offset:128 sc1
L_poll2:
    global_load_dwordx4 v[8:11], v3, s[16:17] sc1
    global_load_dwordx4 v[12:15], v3, s[16:17] offset:1024 sc1
    s_mov_b32 s46, 1
L_chk2:
    v_cmp_eq_u64 vcc, s[24:25], v[10:11]
    v_cmp_eq_u64 s[30:31], s[24:25], v[14:15]
    s_and_b64 vcc, vcc, s[30:31]
    s_cmp_eq_u64 vcc, exec
    s_cbranch_scc1 L_done2
    s_sub_u32 s46, s46, 1
    s_cbranch_scc0 L_chk2
    s_sub_u32 s44, s44, 1
    s_cbranch_scc0 L_poll2
L_done2:
    v_pk_add_f32 v[16:17], v[8:9], v[12:13]
    s_mov_b64 exec, -1
    s_nop 0
    v_permlane32_swap_b32 v16, v17
    v_add_f32 v16, v16, v17
    s_nop 1
    v_add_f32_dpp v16, v16, v16 row_ror:8 row_mask:0xf bank_mask:0xf
    s_nop 1
    v_add_f32_dpp v17, v16, v16 row_ror:4 row_mask:0xf bank_mask:0xf
    v_add_f32_dpp v16, v16, v16 row_ror:4 row_mask:0xf bank_mask:0xf
    s_nop 1
    v_permlane16_swap_b32 v16, v17
    s_mov_b64 exec, s[38:39]
    v_add_f32 v16, v16, v17
    v_cvt_pk_bf16_f32 v16, v16, v16
    global_store_short v4, v16, s[12:13]
    s_cmp_lg_u32 s36, 224
    s_cbranch_scc1 L_end
    s_mov_b64 exec, 0xffffffff
    s_mov_b32 exec_hi, 0
L_xall:
    v_cmp_ne_u32 vcc, 0, v18
    s_cmp_eq_u64 vcc, exec
    s_cbranch_scc1 L_xok
    global_load_dword v18, v7, s[14:15] offset:128 sc1
    s_waitcnt vmcnt(0)
    s_sub_u32 s44, s44, 1
    s_cbranch_scc0 L_xall
L_xok:
    v_mov_b32 v6, s24
    v_mov_b32 v7, s25
    v_mov_b32 v5, 0
    s_mov_b64 exec, 1
    global_store_dwordx2 v5, v[6:7], s[16:17]
L_end:
L_exit:
    s_endpgm
.section .rodata,"a"
.p2align 6
.amdhsa_kernel standalone__geglu_ffn__decode_kernel
  .amdhsa_next_free_vgpr 200
  .amdhsa_next_free_sgpr 48
  .amdhsa_accum_offset 200
  .amdhsa_group_segment_fixed_size 0
  .amdhsa_kernarg_size 56
  .amdhsa_user_sgpr_count 2
  .amdhsa_user_sgpr_kernarg_segment_ptr 1
  .amdhsa_system_sgpr_workgroup_id_x 1
  .amdhsa_float_denorm_mode_32 3
.end_amdhsa_kernel
```
